```python
import torch

def _softmax(x, axis=-1):
    return torch.softmax(x, dim=axis)
def _gelu(x):
    return torch.nn.functional.gelu(x, approximate="tanh")
def _silu(x):
    return torch.nn.functional.silu(x)
def _sigmoid(x):
    return torch.sigmoid(x)
def _layernorm(x, axis=-1, eps=1e-5):
    m = x.mean(dim=axis, keepdim=True)
    v = x.var(dim=axis, keepdim=True, unbiased=False)
    return (x - m) / torch.sqrt(v + eps)
def _scatter_add(tgt, idx, src, axis=0):
    return tgt.clone().index_add_(axis, idx, src)
def _segment_sum(src, seg, n):
    out = torch.zeros((n,) + src.shape[1:], dtype=src.dtype)
    return out.index_add_(0, seg, src)
def _pad(x, pw):
    flat = tuple(v for pair in reversed(pw) for v in pair)
    return torch.nn.functional.pad(x, flat)

kernel_name = 'standalone__instancenorm__sampling'

def setup_inputs():

    _w = (lambda a: (lambda t: t.to(torch.bfloat16) if t.is_floating_point() else t)(torch.as_tensor(a)))
    B, C, H, W = 32, 1024, 32, 32
    return {
        "x": _w(abs((lambda *s: torch.randn(*s, dtype=torch.bfloat16) * 0.05)(B, C, H, W))),
        "g": _w((lambda *s: torch.randn(*s, dtype=torch.bfloat16) * 0.05)(C) + 1.0),
        "b": _w((lambda *s: torch.randn(*s, dtype=torch.bfloat16) * 0.4)(C)),
    }

def reference(x, g, b):
    mu = x.mean(axis=(-2, -1), keepdims=True)
    var = ((x - mu) ** 2).mean(axis=(-2, -1), keepdims=True)
    xhat = (x - mu) / torch.sqrt(var + 1e-5)
    return xhat * g.reshape(1, -1, 1, 1) + b.reshape(1, -1, 1, 1)
```

```asm
; @launch grid=(256,1,1) block=(640,1,1) lds=98304
.amdgcn_target "amdgcn-amd-amdhsa--gfx950"
.text
.globl standalone__instancenorm__sampling_kernel
.p2align 8
.type standalone__instancenorm__sampling_kernel,@function
standalone__instancenorm__sampling_kernel:

    s_load_dwordx2 s[4:5], s[0:1], 0
    s_load_dwordx4 s[12:15], s[0:1], 8
    s_load_dwordx2 s[8:9], s[0:1], 24
    s_load_dwordx2 s[16:17], s[0:1], 32
    s_cmpk_ge_u32 s2, 256
    s_cbranch_scc1 L_end
    s_getpc_b64 s[22:23]
    v_mov_b32 v1, 0
    v_lshl_add_u64 v[14:15], v[0:1], 2, s[22:23]
    global_load_dword v47, v[14:15], off
    v_lshrrev_b32 v1, 6, v0
    v_and_b32 v3, 63, v0
    v_readfirstlane_b32 s3, v1
    v_lshlrev_b32 v2, 4, v3
    v_lshlrev_b32 v3, 2, v3
    s_mov_b32 s6, 0x4000000
    s_mov_b32 s7, 0x20000
    s_lshr_b32 s18, s2, 3
    s_and_b32 s19, s2, 3
    s_lshl2_add_u32 s18, s18, s19
    s_lshl_b32 s38, s18, 16
    s_and_b32 s19, s3, 12
    s_add_u32 s21, s19, s3
    s_xor_b32 s19, s2, s3
    s_and_b32 s19, s19, 4
    s_or_b32 s21, s21, s19
    s_lshl_b32 s21, s21, 11
    s_or_b32 s21, s21, s38
    s_mul_i32 s18, s2, 0x2500
    s_and_b32 s18, s18, 0x2f00
    s_bitset1_b32 s18, 16
    s_xor_b32 s18, s18, s38
    s_xor_b32 s19, s18, 0x2000
    s_cmp_lg_u32 s3, 0
    s_waitcnt lgkmcnt(0)
    buffer_load_dwordx4 v[4:7], v2, s[4:7], s21 offen nt
    buffer_load_dwordx4 v[8:11], v2, s[4:7], s21 offen offset:1024 nt
    s_cbranch_scc1 L_rest
L_m0:
    s_load_dword s23, s[4:5], s18 offset:0x9000 glc
    s_load_dword s22, s[4:5], s19 offset:0x9000 glc
    s_getreg_b32 s27, hwreg(HW_REG_XCC_ID)
    s_add_u32 s25, s18, s4
    s_lshr_b32 s20, s25, 8
    s_waitcnt lgkmcnt(1)
    s_memtime s[30:31]
    s_waitcnt lgkmcnt(0)
    s_memtime s[32:33]
L_m1:
    .if ((L_m0 - standalone__instancenorm__sampling_kernel) >> 6) != ((L_m1 - 1 - standalone__instancenorm__sampling_kernel) >> 6)
    .error "measurement crosses an instruction-cache line"
    .endif
    s_xor_b32 s25, s25, s20
    s_lshr_b32 s25, s25, 11
    s_xor_b32 s25, s25, s27
    s_and_b32 s25, s25, 4
    s_sub_u32 s27, s27, s2
    s_add_u32 s34, s25, s27
    s_and_b32 s34, s34, 7
    s_bitset1_b32 s34, 31
    s_mov_b32 s35, 0
    s_waitcnt lgkmcnt(0)
    s_sub_u32 s32, s32, s30
    s_cmpk_lt_u32 s32, 100
    s_cselect_b32 s18, s19, s18
    s_and_b32 s18, s18, 0x2000
    s_or_b32 s18, s18, 10
    v_mov_b32 v12, s18
    ds_write_b32 v3, v12
    s_cmpk_lt_u32 s32, 160
    s_cselect_b32 s20, 64, s2
    s_waitcnt lgkmcnt(0)
    s_cmp_ge_u32 s20, 64
    s_cbranch_scc1 L_novote
    s_atomic_cmpswap s[34:35], s[16:17], 128
L_novote:
    s_barrier
L_rest:
    s_lshr_b32 s24, s38, 10
    s_and_b32 s24, s24, 0x7c0
    v_and_b32 v1, 31, v0
    v_lshl_add_u32 v1, v1, 1, s24
    v_mov_b32 v45, 0
    v_mov_b32 v46, 0
    global_load_short_d16_hi v45, v1, s[12:13]
    global_load_short_d16_hi v46, v1, s[14:15]
    s_mov_b32 s10, 0x4000000
    s_mov_b32 s11, 0x20000
    s_mov_b32 s26, 0x3f803f80
    v_mov_b32 v32, 0x3f80
    v_mov_b32 v33, 0x3f800000
    v_mov_b32 v34, 1
    s_and_b32 s22, s2, 4
    v_lshrrev_b32 v16, 2, v3
    v_subrev_u32 v17, 20, v16
    v_add_u32 v18, 1, v17
    v_mul_u32_u24 v18, 410, v18
    v_lshrrev_b32 v18, 12, v18
    v_mul_u32_u24 v19, 10, v18
    v_min_u32 v20, 8, v18
    v_sub_u32 v20, v16, v20
    v_add_u32 v20, 8, v20
    v_mov_b32 v21, 1
    v_subrev_u32 v19, 1, v19
    v_cmp_eq_u32 vcc, v19, v17
    v_cmp_ge_u32 s[42:43], 8, v18
    s_and_b64 vcc, vcc, s[42:43]
    v_subrev_u32 v18, 1, v18
    v_mov_b32 v22, 0x2002
    v_cmp_gt_u32 s[42:43], 20, v16
    v_subrev_u32 v19, 12, v16
    s_nop 0
    v_cndmask_b32 v18, v18, v19, s[42:43]
    v_cndmask_b32 v22, v22, 2, s[42:43]
    s_or_b64 vcc, vcc, s[42:43]
    v_and_b32 v19, 0xfc, v18
    v_add3_u32 v19, v19, v18, s22
    v_add_u32 v19, 12, v19
    v_cndmask_b32 v20, v20, v19, vcc
    v_cndmask_b32 v21, v21, v22, vcc
    v_xor_b32 v19, s2, v16
    v_and_b32 v19, 4, v19
    v_lshlrev_b32 v19, 11, v19
    v_cmp_gt_u32 vcc, 12, v16
    s_nop 1
    v_cndmask_b32 v20, v20, v16, vcc
    v_cndmask_b32 v21, v21, v19, vcc
    v_and_b32 v18, 15, v20
    v_and_b32 v19, 12, v20
    v_add_lshl_u32 v18, v18, v19, 11
    v_lshrrev_b32 v20, 4, v20
    v_lshl_or_b32 v18, v20, 23, v18
    v_or3_b32 v48, v18, v21, s38
    v_lshrrev_b32 v16, 2, v3
    v_add_u32 v16, 64, v16
    v_subrev_u32 v17, 20, v16
    v_add_u32 v18, 1, v17
    v_mul_u32_u24 v18, 410, v18
    v_lshrrev_b32 v18, 12, v18
    v_mul_u32_u24 v19, 10, v18
    v_min_u32 v20, 8, v18
    v_sub_u32 v20, v16, v20
    v_add_u32 v20, 8, v20
    v_mov_b32 v21, 1
    v_subrev_u32 v19, 1, v19
    v_cmp_eq_u32 vcc, v19, v17
    v_cmp_ge_u32 s[42:43], 8, v18
    s_and_b64 vcc, vcc, s[42:43]
    v_subrev_u32 v18, 1, v18
    v_mov_b32 v22, 0x2002
    v_and_b32 v19, 0xfc, v18
    v_add3_u32 v19, v19, v18, s22
    v_add_u32 v19, 12, v19
    v_cndmask_b32 v20, v20, v19, vcc
    v_cndmask_b32 v21, v21, v22, vcc
    v_and_b32 v18, 15, v20
    v_and_b32 v19, 12, v20
    v_add_lshl_u32 v18, v18, v19, 11
    v_lshrrev_b32 v20, 4, v20
    v_lshl_or_b32 v18, v20, 23, v18
    v_or3_b32 v49, v18, v21, s38
    s_mov_b32 s39, 20
    s_mov_b32 s37, 0
    s_mov_b32 s45, 0
    s_mov_b32 s24, 1
    s_mov_b32 s40, -1
    s_mov_b32 s46, 1
    s_cmp_le_i32 s3, 0
    s_cbranch_scc1 L_w0
    s_barrier
L_w0:
    s_bfe_u32 s47, s21, 0x5000b
L_loop:
    v_mov_b32 v12, 0
    v_mov_b32 v13, 0
    s_mov_b32 s20, s21
    s_mov_b32 s43, s47
    s_waitcnt vmcnt(3)
    ds_add_rtn_u32 v35, v3, v34
    v_dot2c_f32_bf16 v12, s26, v4
    v_dot2c_f32_bf16 v13, s26, v5
    v_dot2c_f32_bf16 v12, s26, v6
    v_dot2c_f32_bf16 v13, s26, v7
    s_waitcnt vmcnt(2)
    v_dot2c_f32_bf16 v12, s26, v8
    v_dot2c_f32_bf16 v13, s26, v9
    v_dot2c_f32_bf16 v12, s26, v10
    v_dot2c_f32_bf16 v13, s26, v11
    s_nop 2
    v_add_f32 v12, v12, v13
    s_nop 1
    v_add_f32_dpp v12, v12, v12 quad_perm:[1,0,3,2] row_mask:0xf bank_mask:0xf
    s_nop 1
    v_add_f32_dpp v12, v12, v12 quad_perm:[2,3,0,1] row_mask:0xf bank_mask:0xf
    s_nop 1
    v_add_f32_dpp v12, v12, v12 row_half_mirror row_mask:0xf bank_mask:0xf
    s_nop 1
    v_add_f32_dpp v12, v12, v12 row_mirror row_mask:0xf bank_mask:0xf
    s_nop 1
    v_add_f32_dpp v12, v12, v12 row_bcast:15 row_mask:0xa bank_mask:0xf
    s_nop 1
    v_add_f32_dpp v12, v12, v12 row_bcast:31 row_mask:0xc bank_mask:0xf
    v_mul_f32 v12, 0xba800000, v12
    v_cvt_pk_bf16_f32 v12, 0, v12
    s_waitcnt lgkmcnt(0)
    v_readlane_b32 s28, v12, 63
    v_readfirstlane_b32 s33, v35
    s_nop 0
    v_dot2_f32_bf16 v16, v4, v32, s28
    v_dot2_f32_bf16 v17, v4, v33, s28
    s_and_b32 s27, s33, 0xff
    v_dot2_f32_bf16 v18, v5, v32, s28
    v_dot2_f32_bf16 v19, v5, v33, s28
    v_dot2_f32_bf16 v20, v6, v32, s28
    v_dot2_f32_bf16 v21, v6, v33, s28
    v_readlane_b32 s18, v48, s27
    v_readlane_b32 s19, v49, s27
    v_dot2_f32_bf16 v22, v7, v32, s28
    v_dot2_f32_bf16 v23, v7, v33, s28
    s_and_b32 s25, s33, 0x2000
    v_dot2_f32_bf16 v24, v8, v32, s28
    v_dot2_f32_bf16 v25, v8, v33, s28
    s_bitcmp1_b32 s27, 6
    s_cselect_b32 s21, s19, s18
    v_dot2_f32_bf16 v26, v9, v32, s28
    v_dot2_f32_bf16 v27, v9, v33, s28
    s_bitcmp1_b32 s21, 1
    s_cselect_b32 s19, s25, 0
    v_dot2_f32_bf16 v28, v10, v32, s28
    v_dot2_f32_bf16 v29, v10, v33, s28
    s_xor_b32 s21, s21, s19
    v_dot2_f32_bf16 v30, v11, v32, s28
    v_dot2_f32_bf16 v31, v11, v33, s28
    s_cmp_ge_u32 s27, s39
    s_cbranch_scc1 L_special
L_half:
    s_bitcmp1_b32 s21, 0
    s_cselect_b32 s19, s37, 0
    s_xor_b32 s21, s21, s19
    s_andn2_b32 s21, s21, 3
    s_bfe_u32 s47, s21, 0x5000b
L_load:
    buffer_load_dwordx4 v[4:7], v2, s[4:7], s21 offen nt
    buffer_load_dwordx4 v[8:11], v2, s[4:7], s21 offen offset:1024 nt
L_noload:
    v_pk_mul_f32 v[12:13], v[16:17], v[16:17]
    v_pk_mul_f32 v[14:15], v[18:19], v[18:19]
    v_pk_fma_f32 v[12:13], v[20:21], v[20:21], v[12:13]
    v_pk_fma_f32 v[14:15], v[22:23], v[22:23], v[14:15]
    v_pk_fma_f32 v[12:13], v[24:25], v[24:25], v[12:13]
    v_pk_fma_f32 v[14:15], v[26:27], v[26:27], v[14:15]
    v_pk_fma_f32 v[12:13], v[28:29], v[28:29], v[12:13]
    v_pk_fma_f32 v[14:15], v[30:31], v[30:31], v[14:15]
    v_pk_add_f32 v[12:13], v[12:13], v[14:15]
    v_add_f32 v12, v12, v13
    s_nop 1
    v_add_f32_dpp v12, v12, v12 quad_perm:[1,0,3,2] row_mask:0xf bank_mask:0xf
    s_nop 1
    v_add_f32_dpp v12, v12, v12 quad_perm:[2,3,0,1] row_mask:0xf bank_mask:0xf
    s_nop 1
    v_add_f32_dpp v12, v12, v12 row_half_mirror row_mask:0xf bank_mask:0xf
    s_nop 1
    v_add_f32_dpp v12, v12, v12 row_mirror row_mask:0xf bank_mask:0xf
    s_nop 1
    v_add_f32_dpp v12, v12, v12 row_bcast:15 row_mask:0xa bank_mask:0xf
    s_nop 1
    v_add_f32_dpp v12, v12, v12 row_bcast:31 row_mask:0xc bank_mask:0xf
    v_mul_f32 v12, 0x3a800000, v12
    v_cvt_pk_bf16_f32 v12, 0, v12
    v_add_f32 v12, 0x3727c5ac, v12
    v_cvt_pk_bf16_f32 v12, 0, v12
    v_sqrt_f32 v12, v12
    s_cmp_lg_u32 s24, 0
    s_cbranch_scc1 L_first
L_gb:
    v_readlane_b32 s29, v45, s43
    v_cvt_pk_bf16_f32 v12, 0, v12
    v_rcp_f32 v12, v12
    v_readlane_b32 s31, v46, s43
    v_mul_f32 v12, s29, v12
    s_nop 0
    v_readlane_b32 s30, v12, 63
    s_nop 1
    v_pk_fma_f32 v[16:17], v[16:17], s[30:31], s[30:31] op_sel:[0,0,1] op_sel_hi:[1,0,1]
    v_pk_fma_f32 v[18:19], v[18:19], s[30:31], s[30:31] op_sel:[0,0,1] op_sel_hi:[1,0,1]
    v_pk_fma_f32 v[20:21], v[20:21], s[30:31], s[30:31] op_sel:[0,0,1] op_sel_hi:[1,0,1]
    v_pk_fma_f32 v[22:23], v[22:23], s[30:31], s[30:31] op_sel:[0,0,1] op_sel_hi:[1,0,1]
    v_pk_fma_f32 v[24:25], v[24:25], s[30:31], s[30:31] op_sel:[0,0,1] op_sel_hi:[1,0,1]
    v_pk_fma_f32 v[26:27], v[26:27], s[30:31], s[30:31] op_sel:[0,0,1] op_sel_hi:[1,0,1]
    v_pk_fma_f32 v[28:29], v[28:29], s[30:31], s[30:31] op_sel:[0,0,1] op_sel_hi:[1,0,1]
    v_pk_fma_f32 v[30:31], v[30:31], s[30:31], s[30:31] op_sel:[0,0,1] op_sel_hi:[1,0,1]
    v_cvt_pk_bf16_f32 v36, v16, v17
    v_cvt_pk_bf16_f32 v37, v18, v19
    v_cvt_pk_bf16_f32 v38, v20, v21
    v_cvt_pk_bf16_f32 v39, v22, v23
    buffer_store_dwordx4 v[36:39], v2, s[8:11], s20 offen sc1
    v_cvt_pk_bf16_f32 v40, v24, v25
    v_cvt_pk_bf16_f32 v41, v26, v27
    v_cvt_pk_bf16_f32 v42, v28, v29
    v_cvt_pk_bf16_f32 v43, v30, v31
    buffer_store_dwordx4 v[40:43], v2, s[8:11], s20 offen offset:1024 sc1
    s_cmp_lg_u32 s45, 0
    s_cbranch_scc1 L_rank
L_next:
    s_cmp_lg_u32 s46, 0
    s_cbranch_scc1 L_loop
L_end:
    s_endpgm
L_first:
    s_mov_b32 s24, 0
    s_waitcnt vmcnt(2)
    s_cmp_lg_u32 s46, 0
    s_cbranch_scc1 L_gb
    s_waitcnt vmcnt(0)
    s_branch L_gb
L_rank:
    s_waitcnt lgkmcnt(0)
    s_lshl_b32 s44, s44, 16
    s_bitset1_b32 s44, 24
    v_mov_b32 v12, s44
    ds_add_u32 v3, v12
    s_mov_b32 s45, 0
    s_branch L_next
L_special:
    s_cmp_eq_u32 s39, 20
    s_cbranch_scc1 L_decide
L_late:
    s_cmpk_ge_u32 s27, 112
    s_cbranch_scc1 L_pool
    s_cmp_lg_u32 s27, s39
    s_cbranch_scc1 L_half
    s_mov_b32 s44, 1
    s_mov_b32 s45, 1
    s_lshl_b32 s19, s42, 6
    s_atomic_add s44, s[16:17], s19 offset:8 glc
    s_branch L_half
L_pool:
    s_cmp_lg_u32 s40, -1
    s_cbranch_scc1 L_share
L_wait:
    s_bitcmp1_b32 s33, 24
    s_cbranch_scc1 L_ranked
    ds_read_b32 v12, v3
    s_waitcnt lgkmcnt(0)
    v_readfirstlane_b32 s33, v12
    s_branch L_wait
L_ranked:
    s_bfe_u32 s32, s33, 0x7000f
    s_sub_i32 s34, s32, 64
    s_mul_i32 s35, s34, s34
    s_sub_i32 s35, 0x1000, s35
    s_mul_i32 s34, s34, s35
    s_mul_i32 s34, s34, 587
    s_ashr_i32 s34, s34, 14
    s_sub_i32 s19, 0x2000, s35
    s_mul_i32 s19, s19, s35
    s_lshr_b32 s19, s19, 8
    s_mul_i32 s19, s19, 772
    s_lshr_b32 s19, s19, 12
    s_add_i32 s34, s34, s19
    s_mul_i32 s35, s35, 1704
    s_lshr_b32 s35, s35, 8
    s_add_i32 s34, s34, s35
    s_ashr_i32 s34, s34, 8
    s_mul_i32 s35, s32, 16
    s_add_i32 s40, s34, s35
    s_lshr_b32 s40, s40, 1
    s_add_u32 s32, s32, 2
    s_sub_i32 s34, s32, 64
    s_mul_i32 s35, s34, s34
    s_sub_i32 s35, 0x1000, s35
    s_mul_i32 s34, s34, s35
    s_mul_i32 s34, s34, 587
    s_ashr_i32 s34, s34, 14
    s_sub_i32 s19, 0x2000, s35
    s_mul_i32 s19, s19, s35
    s_lshr_b32 s19, s19, 8
    s_mul_i32 s19, s19, 772
    s_lshr_b32 s19, s19, 12
    s_add_i32 s34, s34, s19
    s_mul_i32 s35, s35, 1704
    s_lshr_b32 s35, s35, 8
    s_add_i32 s34, s34, s35
    s_ashr_i32 s34, s34, 8
    s_mul_i32 s35, s32, 16
    s_add_i32 s41, s34, s35
    s_lshr_b32 s41, s41, 1
    s_sub_u32 s41, s41, s40
    s_add_u32 s41, s41, 32
    s_and_b32 s19, s42, 1
    s_mul_i32 s19, s19, 1024
    s_add_u32 s19, s19, s40
    s_sub_u32 s19, s19, 32
    v_lshrrev_b32 v12, 2, v3
    v_add_u32 v12, s19, v12
    v_and_b32 v13, -4, v12
    v_add_lshl_u32 v12, v12, v13, 11
    v_add_u32 v12, 0x3800000, v12
    v_add_u32 v13, s4, v12
    v_lshrrev_b32 v14, 8, v13
    v_xor_b32 v13, v13, v14
    v_xor_b32 v13, s36, v13
    v_and_b32 v13, 0x2000, v13
    v_or_b32 v50, v12, v13
    v_bfe_u32 v12, v50, 11, 10
    v_lshlrev_b32 v12, 1, v12
    s_mov_b32 exec_lo, 0
    global_load_short_d16_hi v45, v12, s[12:13]
    global_load_short_d16_hi v46, v12, s[14:15]
    s_mov_b32 exec_lo, -1
L_share:
    s_sub_u32 s47, s27, 80
    s_cmp_ge_u32 s47, s41
    s_cbranch_scc1 L_over
    v_readlane_b32 s21, v50, s47
    s_nop 3
    s_branch L_load
L_over:
    s_mov_b32 s46, 0
    s_andn2_b32 s21, s18, 0x2003
    s_or_b32 s21, s21, s37
    s_bitset1_b32 s21, 24
    buffer_load_dwordx4 v[4:7], v2, s[4:7], s21 offen nt
    s_branch L_noload
L_decide:
    s_load_dword s23, s[16:17], 128
    s_add_u32 s22, s38, s4
    s_lshr_b32 s19, s22, 8
    s_xor_b32 s22, s22, s19
    s_waitcnt lgkmcnt(0)
    s_bitcmp1_b32 s23, 31
    s_cbranch_scc0 L_slow
L_have:
    s_add_u32 s23, s23, s2
    s_lshl_b32 s23, s23, 11
    s_and_b32 s36, s23, 0x2000
    s_xor_b32 s22, s22, s23
    s_and_b32 s37, s22, 0x2000
    s_bfe_u32 s42, s2, 0x10003
    s_lshr_b32 s19, s36, 12
    s_or_b32 s42, s42, s19
    s_mul_i32 s39, s42, 5
    s_add_u32 s39, s39, 88
    s_branch L_late
L_slow:
    s_lshr_b32 s19, s2, 3
    s_add_u32 s19, s19, 4
    v_mov_b32 v13, 0
L_retry:
    global_load_dword v12, v13, s[16:17] offset:128 sc1
    s_waitcnt vmcnt(0)
    v_readfirstlane_b32 s23, v12
    s_bitcmp1_b32 s23, 31
    s_cbranch_scc1 L_have
    s_sub_u32 s19, s19, 1
    s_cmp_lg_u32 s19, 0
    s_cbranch_scc1 L_retry
    s_getreg_b32 s32, hwreg(HW_REG_XCC_ID)
    s_xor_b32 s34, s22, s25
    s_lshr_b32 s34, s34, 11
    s_xor_b32 s34, s34, s32
    s_and_b32 s34, s34, 4
    s_sub_u32 s32, s32, s2
    s_add_u32 s34, s34, s32
    s_and_b32 s34, s34, 7
    s_bitset1_b32 s34, 31
    s_mov_b32 s23, s34
    s_mov_b32 s35, 0
    s_atomic_cmpswap s[34:35], s[16:17], 128 glc
    s_waitcnt lgkmcnt(0)
    s_cmp_eq_u32 s34, 0
    s_cselect_b32 s23, s23, s34
    s_branch L_have
    .if (. - standalone__instancenorm__sampling_kernel) < 2624
    .fill (2560 + 64 - (. - standalone__instancenorm__sampling_kernel)) / 4, 4, 0xbf810000
    .endif
.section .rodata,"a"
.p2align 6
.amdhsa_kernel standalone__instancenorm__sampling_kernel
  .amdhsa_next_free_vgpr 52
  .amdhsa_next_free_sgpr 48
  .amdhsa_accum_offset 52
  .amdhsa_group_segment_fixed_size 0
  .amdhsa_kernarg_size 48
  .amdhsa_user_sgpr_count 2
  .amdhsa_user_sgpr_kernarg_segment_ptr 1
  .amdhsa_system_sgpr_workgroup_id_x 1
  .amdhsa_float_denorm_mode_32 3
.end_amdhsa_kernel
```
